```python
import torch

def _softmax(x, axis=-1):
    return torch.softmax(x, dim=axis)
def _gelu(x):
    return torch.nn.functional.gelu(x, approximate="tanh")
def _silu(x):
    return torch.nn.functional.silu(x)
def _sigmoid(x):
    return torch.sigmoid(x)
def _layernorm(x, axis=-1, eps=1e-5):
    m = x.mean(dim=axis, keepdim=True)
    v = x.var(dim=axis, keepdim=True, unbiased=False)
    return (x - m) / torch.sqrt(v + eps)
def _scatter_add(tgt, idx, src, axis=0):
    return tgt.clone().index_add_(axis, idx, src)
def _segment_sum(src, seg, n):
    out = torch.zeros((n,) + src.shape[1:], dtype=src.dtype)
    return out.index_add_(0, seg, src)
def _pad(x, pw):
    flat = tuple(v for pair in reversed(pw) for v in pair)
    return torch.nn.functional.pad(x, flat)

kernel_name = 'standalone__sliding_block_cached__decode'

def setup_inputs():

    _w = (lambda a: (lambda t: t.to(torch.bfloat16) if t.is_floating_point() else t)(torch.as_tensor(a)))
    B, Sq, D = 1, 1, 512
    Hq, Hkv, Sk, Dh = 32, 8, 32768, 128
    assert Hq % Hkv == 0, (Hq, Hkv)
    return {
        "x": _w((lambda *s: torch.randn(*s, dtype=torch.bfloat16) * 0.8)(B, Sq, D)),
        "k_cache": _w((lambda *s: torch.randn(*s, dtype=torch.bfloat16) * 0.8)(B, Hkv, Sk, Dh)),
        "v_cache": _w((lambda *s: torch.randn(*s, dtype=torch.bfloat16) * 0.05)(B, Hkv, Sk, Dh)),
        "wq": _w((lambda *s: torch.randn(*s, dtype=torch.bfloat16) * 0.8)(D, Hq * Dh) * (D ** -0.5)),
        "wo": _w((lambda *s: torch.randn(*s, dtype=torch.bfloat16) * 0.05)(Hq * Dh, D) * ((Hq * Dh) ** -0.5)),
    }

def reference(x, k_cache, v_cache, wq, wo):
    B, Sq, D = x.shape
    Hq, Dh = 32, 128
    Hkv, Sk = k_cache.shape[1], k_cache.shape[2]
    W = min(4096, max(256, Sk // 4))
    rep = Hq // Hkv
    q = (lambda x, *d: x.permute(*d))((x @ wq).reshape(B, Sq, Hq, Dh), 0, 2, 1, 3)
    k = (lambda x, n, axis: torch.repeat_interleave(x, n, dim=axis))(k_cache[:, :, Sk - W:, :], rep, axis=1)
    v = (lambda x, n, axis: torch.repeat_interleave(x, n, dim=axis))(v_cache[:, :, Sk - W:, :], rep, axis=1)
    scores = torch.einsum("bhqd,bhkd->bhqk", q, k) * (Dh ** -0.5)
    p = _softmax(scores, axis=-1)
    o = torch.einsum("bhqk,bhkd->bhqd", p, v)
    return (lambda x, *d: x.permute(*d))(o, 0, 2, 1, 3).reshape(B, Sq, Hq * Dh) @ wo
```

```asm
; @launch grid=(256,1,1) block=(512,1,1) lds=95232
.amdgcn_target "amdgcn-amd-amdhsa--gfx950"
.text
    .globl standalone__sliding_block_cached__decode_kernel
    .p2align 8
    .type standalone__sliding_block_cached__decode_kernel,@function
standalone__sliding_block_cached__decode_kernel:
    s_cmp_ge_u32 s2, 256
    s_cbranch_scc1 L_exit
    s_memrealtime s[42:43]
    s_load_dwordx16 s[4:19], s[0:1], 0
    s_and_b32 s20, s2, 7
    s_lshr_b32 s21, s2, 3
    v_and_b32 v1, 63, v0
    v_lshrrev_b32 v2, 6, v0
    v_mov_b32 v3, 0
    s_lshr_b32 s26, s21, 3
    s_lshl_b32 s27, s20, 2
    s_add_u32 s34, s26, s27
    s_and_b32 s35, s21, 7
    v_readfirstlane_b32 s25, v2
    v_mov_b32 v4, 0
    v_mov_b32 v5, 0
    v_mov_b32 v6, 0
    v_mov_b32 v7, 0
    v_lshlrev_b32 v8, 4, v1
    s_mov_b64 exec, 0x3f
    ds_write_b128 v8, v[4:7] offset:3072
    s_mov_b64 exec, -1
    s_waitcnt lgkmcnt(0)
    s_barrier
    global_load_dword v4, v3, s[18:19] sc1
    s_cmp_ge_u32 s25, 4
    s_cbranch_scc1 L_bwave
    s_lshl_b32 s26, s20, 10
    s_lshr_b32 s27, s21, 1
    s_lshl_b32 s27, s27, 6
    s_add_u32 s26, s26, s27
    s_and_b32 s28, s21, 1
    s_lshl_b32 s27, s28, 21
    s_add_u32 s26, s26, s27
    v_lshrrev_b32 v5, 2, v0
    v_lshlrev_b32 v6, 1, v5
    s_lshl_b32 s27, s28, 9
    v_add_u32 v6, s27, v6
    v_lshlrev_b32 v5, 13, v5
    v_and_b32 v7, 3, v0
    v_lshl_add_u32 v5, v7, 4, v5
    v_add_u32 v5, s26, v5
    global_load_ushort v24, v6, s[4:5] offset:0
    global_load_ushort v25, v6, s[4:5] offset:128
    global_load_ushort v26, v6, s[4:5] offset:256
    global_load_ushort v27, v6, s[4:5] offset:384
    global_load_dwordx4 v[8:11], v5, s[10:11] nt
    v_add_u32 v5, 0x80000, v5
    global_load_dwordx4 v[12:15], v5, s[10:11] nt
    v_add_u32 v5, 0x80000, v5
    global_load_dwordx4 v[16:19], v5, s[10:11] nt
    v_add_u32 v5, 0x80000, v5
    global_load_dwordx4 v[20:23], v5, s[10:11] nt
    s_waitcnt vmcnt(8)
    v_readfirstlane_b32 s23, v4
    s_mul_i32 s22, s23, 0x9E3779B1
    s_add_u32 s22, s22, 0x7F4A7C15
    s_cmp_lg_u32 s25, 0
    s_cbranch_scc1 L_noprew
    s_lshl_b32 s26, s20, 13
    s_add_u32 s26, s26, 2359296
    s_lshr_b32 s27, s21, 1
    s_lshl_b32 s27, s27, 9
    s_add_u32 s26, s26, s27
    s_lshl_b32 s27, s28, 4
    s_add_u32 s26, s26, s27
    v_lshlrev_b32 v41, 4, v1
    v_add_u32 v41, s26, v41
    s_not_b32 s27, s22
    v_mov_b32 v30, 0
    v_mov_b32 v31, s27
    v_mov_b32 v32, 0
    v_mov_b32 v33, s27
    s_mov_b32 exec_lo, 0x55555555
    s_mov_b32 exec_hi, 0
    v_add_u32 v41, 0x10000, v41
    global_store_dwordx4 v41, v[30:33], s[18:19]
    s_mov_b64 exec, -1
L_noprew:
    v_lshrrev_b32 v5, 4, v0
    v_lshlrev_b32 v5, 7, v5
    v_lshl_add_u32 v5, v7, 5, v5
    v_and_b32 v6, 15, v0
    v_lshlrev_b32 v38, 2, v2
    v_mov_b32 v39, 1
    v_mov_b32 v28, 0
    v_mov_b32 v29, 0
    v_mov_b32 v30, 0
    v_mov_b32 v31, 0
    v_mov_b32 v32, 0
    v_mov_b32 v33, 0
    v_mov_b32 v34, 0
    v_mov_b32 v35, 0
    s_cmp_lg_u32 s25, 0
    s_cbranch_scc1 L_prew0
    s_waitcnt vmcnt(1)
    s_branch L_prew1
L_prew0:
    s_waitcnt vmcnt(0)
L_prew1:
    v_lshlrev_b32 v24, 16, v24
    v_lshlrev_b32 v25, 16, v25
    v_lshlrev_b32 v26, 16, v26
    v_lshlrev_b32 v27, 16, v27
    v_lshlrev_b32 v36, 16, v8
    v_and_b32 v37, 0xffff0000, v8
    v_fmac_f32 v28, v24, v36
    v_fmac_f32 v29, v24, v37
    v_lshlrev_b32 v36, 16, v9
    v_and_b32 v37, 0xffff0000, v9
    v_fmac_f32 v30, v24, v36
    v_fmac_f32 v31, v24, v37
    v_lshlrev_b32 v36, 16, v10
    v_and_b32 v37, 0xffff0000, v10
    v_fmac_f32 v32, v24, v36
    v_fmac_f32 v33, v24, v37
    v_lshlrev_b32 v36, 16, v11
    v_and_b32 v37, 0xffff0000, v11
    v_fmac_f32 v34, v24, v36
    v_fmac_f32 v35, v24, v37
    v_lshlrev_b32 v36, 16, v12
    v_and_b32 v37, 0xffff0000, v12
    v_fmac_f32 v28, v25, v36
    v_fmac_f32 v29, v25, v37
    v_lshlrev_b32 v36, 16, v13
    v_and_b32 v37, 0xffff0000, v13
    v_fmac_f32 v30, v25, v36
    v_fmac_f32 v31, v25, v37
    v_lshlrev_b32 v36, 16, v14
    v_and_b32 v37, 0xffff0000, v14
    v_fmac_f32 v32, v25, v36
    v_fmac_f32 v33, v25, v37
    v_lshlrev_b32 v36, 16, v15
    v_and_b32 v37, 0xffff0000, v15
    v_fmac_f32 v34, v25, v36
    v_fmac_f32 v35, v25, v37
    v_lshlrev_b32 v36, 16, v16
    v_and_b32 v37, 0xffff0000, v16
    v_fmac_f32 v28, v26, v36
    v_fmac_f32 v29, v26, v37
    v_lshlrev_b32 v36, 16, v17
    v_and_b32 v37, 0xffff0000, v17
    v_fmac_f32 v30, v26, v36
    v_fmac_f32 v31, v26, v37
    v_lshlrev_b32 v36, 16, v18
    v_and_b32 v37, 0xffff0000, v18
    v_fmac_f32 v32, v26, v36
    v_fmac_f32 v33, v26, v37
    v_lshlrev_b32 v36, 16, v19
    v_and_b32 v37, 0xffff0000, v19
    v_fmac_f32 v34, v26, v36
    v_fmac_f32 v35, v26, v37
    v_lshlrev_b32 v36, 16, v20
    v_and_b32 v37, 0xffff0000, v20
    v_fmac_f32 v28, v27, v36
    v_fmac_f32 v29, v27, v37
    v_lshlrev_b32 v36, 16, v21
    v_and_b32 v37, 0xffff0000, v21
    v_fmac_f32 v30, v27, v36
    v_fmac_f32 v31, v27, v37
    v_lshlrev_b32 v36, 16, v22
    v_and_b32 v37, 0xffff0000, v22
    v_fmac_f32 v32, v27, v36
    v_fmac_f32 v33, v27, v37
    v_lshlrev_b32 v36, 16, v23
    v_and_b32 v37, 0xffff0000, v23
    v_fmac_f32 v34, v27, v36
    v_fmac_f32 v35, v27, v37
    s_nop 1
    v_add_f32_dpp v28, v28, v28 row_ror:4 row_mask:0xf bank_mask:0xf
    v_add_f32_dpp v29, v29, v29 row_ror:4 row_mask:0xf bank_mask:0xf
    v_add_f32_dpp v30, v30, v30 row_ror:4 row_mask:0xf bank_mask:0xf
    v_add_f32_dpp v31, v31, v31 row_ror:4 row_mask:0xf bank_mask:0xf
    v_add_f32_dpp v32, v32, v32 row_ror:4 row_mask:0xf bank_mask:0xf
    v_add_f32_dpp v33, v33, v33 row_ror:4 row_mask:0xf bank_mask:0xf
    v_add_f32_dpp v34, v34, v34 row_ror:4 row_mask:0xf bank_mask:0xf
    v_add_f32_dpp v35, v35, v35 row_ror:4 row_mask:0xf bank_mask:0xf
    s_nop 1
    v_add_f32_dpp v28, v28, v28 row_ror:8 row_mask:0xf bank_mask:0xf
    v_add_f32_dpp v29, v29, v29 row_ror:8 row_mask:0xf bank_mask:0xf
    v_add_f32_dpp v30, v30, v30 row_ror:8 row_mask:0xf bank_mask:0xf
    v_add_f32_dpp v31, v31, v31 row_ror:8 row_mask:0xf bank_mask:0xf
    v_add_f32_dpp v32, v32, v32 row_ror:8 row_mask:0xf bank_mask:0xf
    v_add_f32_dpp v33, v33, v33 row_ror:8 row_mask:0xf bank_mask:0xf
    v_add_f32_dpp v34, v34, v34 row_ror:8 row_mask:0xf bank_mask:0xf
    v_add_f32_dpp v35, v35, v35 row_ror:8 row_mask:0xf bank_mask:0xf
    s_nop 1
    v_cmp_gt_u32 vcc, 4, v6
    s_and_saveexec_b64 s[36:37], vcc
    ds_write_b128 v5, v[28:31] offset:0
    ds_write_b128 v5, v[32:35] offset:16
    s_mov_b64 exec, 1
    ds_write_b32 v38, v39 offset:3072
    s_mov_b64 exec, s[36:37]
    s_lshl_b32 s26, s20, 13
    s_add_u32 s26, s26, 2359296
    v_lshlrev_b32 v40, 5, v0
    v_add_u32 v40, s26, v40
    v_and_b32 v5, 31, v1
    v_lshlrev_b32 v5, 2, v5
    s_lshr_b32 s27, s21, 1
    s_lshl_b32 s27, s27, 9
    s_add_u32 s26, s26, s27
    s_lshl_b32 s27, s28, 4
    s_add_u32 s26, s26, s27
    v_lshlrev_b32 v41, 4, v1
    v_add_u32 v41, s26, v41
    v_add_u32 v42, 0x10000, v41
    s_cmp_lg_u32 s25, 0
    s_cbranch_scc1 L_qpoll
    v_and_b32 v6, 0x21, v1
    v_mov_b32 v31, s22
    v_mov_b32 v33, s22
L_spin:
    ds_read_b128 v[44:47], v3 offset:3072
    s_waitcnt lgkmcnt(0)
    v_and_b32 v44, v44, v45
    v_and_b32 v46, v46, v47
    v_and_b32 v44, v44, v46
    s_nop 0
    v_readfirstlane_b32 s27, v44
    s_cmp_eq_u32 s27, 0
    s_cbranch_scc1 L_spin
    ds_read_b32 v8, v5 offset:0
    ds_read_b32 v9, v5 offset:128
    ds_read_b32 v10, v5 offset:256
    ds_read_b32 v11, v5 offset:384
    ds_read_b32 v12, v5 offset:512
    ds_read_b32 v13, v5 offset:640
    ds_read_b32 v14, v5 offset:768
    ds_read_b32 v15, v5 offset:896
    ds_read_b32 v16, v5 offset:1024
    ds_read_b32 v17, v5 offset:1152
    ds_read_b32 v18, v5 offset:1280
    ds_read_b32 v19, v5 offset:1408
    ds_read_b32 v20, v5 offset:1536
    ds_read_b32 v21, v5 offset:1664
    ds_read_b32 v22, v5 offset:1792
    ds_read_b32 v23, v5 offset:1920
    s_waitcnt lgkmcnt(0)
    v_add_f32 v8, v8, v16
    v_add_f32 v9, v9, v17
    v_add_f32 v10, v10, v18
    v_add_f32 v11, v11, v19
    v_add_f32 v12, v12, v20
    v_add_f32 v13, v13, v21
    v_add_f32 v14, v14, v22
    v_add_f32 v15, v15, v23
    v_add_f32 v8, v8, v12
    v_add_f32 v9, v9, v13
    v_add_f32 v10, v10, v14
    v_add_f32 v11, v11, v15
    v_add_f32 v8, v8, v10
    v_add_f32 v9, v9, v11
    v_add_f32 v8, v8, v9
    v_mov_b32 v30, v8
    s_nop 0
    v_mov_b32_dpp v32, v8 quad_perm:[1,0,3,2] row_mask:0xf bank_mask:0xf
    v_cmp_eq_u32 vcc, 0, v6
    s_and_saveexec_b64 s[36:37], vcc
    global_store_dwordx4 v42, v[30:33], s[18:19]
    s_mov_b64 exec, s[36:37]
L_qpoll:
    v_lshrrev_b32 v7, 4, v1
    v_bfe_u32 v9, v1, 2, 2
    v_lshl_add_u32 v8, v7, 2, v9
    v_lshlrev_b32 v119, 4, v8
    v_and_b32 v9, 7, v8
    v_lshlrev_b32 v9, 1, v9
    v_bfe_u32 v10, v1, 1, 1
    v_xor_b32 v9, v9, v10
    v_lshlrev_b32 v10, 1, v2
    v_xor_b32 v9, v9, v10
    v_lshlrev_b32 v116, 8, v8
    v_lshl_add_u32 v116, v9, 4, v116
    v_and_b32 v10, 1, v1
    v_lshl_add_u32 v116, v10, 3, v116
    v_add_u32 v116, 62464, v116
    v_lshlrev_b32 v146, 2, v7
    s_lshl_b32 s27, s20, 17
    s_lshl_b32 s28, s21, 10
    s_add_u32 s27, s27, s28
    s_add_u32 s27, s27, 65536
    v_and_b32 v149, 15, v1
    v_lshl_add_u32 v147, v2, 4, v149
    v_lshlrev_b32 v147, 3, v147
    v_lshl_add_u32 v147, v7, 15, v147
    v_add_u32 v147, s27, v147
    s_lshl_b32 s27, s20, 11
    s_lshl_b32 s28, s21, 4
    s_add_u32 s27, s27, s28
    s_add_u32 s27, s27, 32768
    v_lshlrev_b32 v148, 9, v7
    v_add_u32 v148, s27, v148
    v_mov_b32 v151, s22
    v_mov_b32 v153, s22
    v_mov_b32 v155, s22
    v_mov_b32 v157, s22
    s_mov_b32 s44, 0x55555555
    s_mov_b32 s45, 0x55555555
    s_mov_b32 s46, 0x00010001
    s_mov_b32 s47, 0x00010001
    v_add_u32 v196, 4194304, v147
    v_add_u32 v197, 4194304, v148
    s_not_b32 s27, s22
    v_mov_b32 v198, 0
    v_mov_b32 v199, s27
    v_mov_b32 v200, 0
    v_mov_b32 v201, s27
    s_mov_b64 exec, s[44:45]
    global_store_dwordx4 v196, v[198:201], s[18:19]
    s_cmp_eq_u32 s25, 0
    s_cselect_b64 exec, s[46:47], 0
    global_store_dwordx4 v197, v[198:201], s[18:19]
    s_mov_b64 exec, -1
    v_and_b32 v6, 15, v1
    v_lshrrev_b32 v7, 4, v1
    v_lshl_add_u32 v112, v2, 5, v6
    v_lshlrev_b32 v112, 8, v112
    v_xor_b32 v8, v7, v6
    v_lshl_add_u32 v112, v8, 4, v112
    v_xor_b32 v113, 64, v112
    v_xor_b32 v114, 128, v112
    v_xor_b32 v115, 192, v112
    v_and_b32 v5, 3, v1
    v_lshl_add_u32 v117, v7, 2, v5
    v_lshlrev_b32 v117, 4, v117
    v_lshl_add_u32 v117, v2, 8, v117
    v_lshl_add_u32 v118, v2, 2, v1
    v_lshlrev_b32 v118, 2, v118
    v_lshlrev_b32 v5, 8, v5
    v_lshl_add_u32 v5, v7, 4, v5
L_qpw:
    ds_read_b32 v159, v38 offset:3152
    s_memrealtime s[40:41]
    s_waitcnt lgkmcnt(0)
    v_readfirstlane_b32 s39, v159
    s_cmp_lg_u32 s39, 0
    s_cbranch_scc1 L_qld
    s_sub_u32 s40, s40, s42
    s_cmp_ge_u32 s40, 260
    s_cbranch_scc1 L_qld
    s_sleep 1
    s_branch L_qpw
L_qld:
    v_add_u32 v43, 0x10000, v40
    s_mov_b32 s38, 0
L_fq:
    global_load_dwordx4 v[136:139], v43, s[18:19] sc1
    global_load_dwordx4 v[140:143], v43, s[18:19] offset:16 sc1
    s_memrealtime s[40:41]
    s_waitcnt vmcnt(0) lgkmcnt(0)
    v_xor_b32 v168, s22, v137
    v_xor_b32 v169, s22, v139
    v_or_b32 v168, v168, v169
    v_xor_b32 v169, s22, v141
    v_or_b32 v168, v168, v169
    v_xor_b32 v169, s22, v143
    v_or_b32 v168, v168, v169
    v_cmp_ne_u32 vcc, 0, v168
    s_sub_u32 s40, s40, s42
    s_add_u32 s38, s38, 1
    s_cmp_eq_u64 vcc, 0
    s_cbranch_scc1 L_fqok
    s_mov_b64 exec, vcc
    s_cmp_lt_u32 s40, 1000
    s_cbranch_scc1 L_fq
    s_mov_b64 exec, -1
    s_cmp_lg_u32 s25, 0
    s_cbranch_scc1 L_qs1
    s_mov_b32 exec_lo, 0x55555555
    s_mov_b32 exec_hi, 0
    global_store_dwordx4 v41, v[30:33], s[18:19] sc1
    s_mov_b64 exec, -1
L_qs1:
    s_mov_b32 s38, 0
L_poll_q:
    global_load_dwordx4 v[136:139], v40, s[18:19] sc1
    global_load_dwordx4 v[140:143], v40, s[18:19] offset:16 sc1
    s_waitcnt vmcnt(0)
    v_xor_b32 v168, s22, v137
    v_xor_b32 v169, s22, v139
    v_or_b32 v168, v168, v169
    v_xor_b32 v169, s22, v141
    v_or_b32 v168, v168, v169
    v_xor_b32 v169, s22, v143
    v_or_b32 v168, v168, v169
    v_cmp_ne_u32 vcc, 0, v168
    s_nop 1
    s_cmp_eq_u64 vcc, 0
    s_cbranch_scc1 L_pollok_q
    s_add_u32 s38, s38, 1
    s_cmp_lt_u32 s38, 0x40000
    s_cbranch_scc0 L_pollok_q
    s_sleep 1
    s_branch L_poll_q
L_pollok_q:
    s_mov_b32 s38, 10
    s_branch L_fqok2
L_fqok:
    s_mov_b64 exec, -1
    s_cmp_lg_u32 s25, 0
    s_cbranch_scc1 L_fqok2
    s_mov_b32 exec_lo, 0x55555555
    s_mov_b32 exec_hi, 0
    global_store_dwordx4 v41, v[30:33], s[18:19] sc1
    s_mov_b64 exec, -1
L_fqok2:
    s_sub_u32 s38, s38, 1
    v_add_f32 v136, v136, v140
    v_add_f32 v138, v138, v142
    v_lshlrev_b32 v8, 2, v0
    v_cvt_pk_bf16_f32 v136, v136, v138
    ds_write_b32 v8, v136 offset:2048
    s_mov_b64 exec, 1
    ds_write_b32 v38, v39 offset:3104
    s_mov_b64 exec, -1
L_qkw:
    ds_read_b128 v[44:47], v3 offset:3104
    ds_read_b32 v48, v38 offset:3088
    s_waitcnt lgkmcnt(0)
    v_and_b32 v44, v44, v45
    v_and_b32 v46, v46, v47
    v_and_b32 v44, v44, v48
    v_and_b32 v44, v44, v46
    s_nop 0
    v_readfirstlane_b32 s27, v44
    s_cmp_eq_u32 s27, 0
    s_cbranch_scc1 L_qkw
    ds_read_b128 v[120:123], v5 offset:2048
    ds_read_b128 v[124:127], v5 offset:2112
    ds_read_b128 v[128:131], v5 offset:2176
    ds_read_b128 v[132:135], v5 offset:2240
    ds_read_b128 v[40:43], v112 offset:29696
    ds_read_b128 v[44:47], v113 offset:29696
    ds_read_b128 v[48:51], v114 offset:29696
    ds_read_b128 v[52:55], v115 offset:29696
    ds_read_b128 v[56:59], v112 offset:33792
    ds_read_b128 v[60:63], v113 offset:33792
    ds_read_b128 v[64:67], v114 offset:33792
    ds_read_b128 v[68:71], v115 offset:33792
    s_waitcnt lgkmcnt(7)
    v_mfma_f32_16x16x32_bf16 v[170:173], v[40:43], v[120:123], 0
    s_waitcnt lgkmcnt(6)
    v_mfma_f32_16x16x32_bf16 v[170:173], v[44:47], v[124:127], v[170:173]
    s_waitcnt lgkmcnt(5)
    v_mfma_f32_16x16x32_bf16 v[170:173], v[48:51], v[128:131], v[170:173]
    s_waitcnt lgkmcnt(4)
    v_mfma_f32_16x16x32_bf16 v[170:173], v[52:55], v[132:135], v[170:173]
    s_waitcnt lgkmcnt(3)
    v_mfma_f32_16x16x32_bf16 v[174:177], v[56:59], v[120:123], 0
    s_waitcnt lgkmcnt(2)
    v_mfma_f32_16x16x32_bf16 v[174:177], v[60:63], v[124:127], v[174:177]
    s_waitcnt lgkmcnt(1)
    v_mfma_f32_16x16x32_bf16 v[174:177], v[64:67], v[128:131], v[174:177]
    s_waitcnt lgkmcnt(0)
    v_mfma_f32_16x16x32_bf16 v[174:177], v[68:71], v[132:135], v[174:177]
    s_mov_b32 s26, 0x3db504f3
    s_mov_b32 s36, 0x000f000f
    s_mov_b32 s37, 0x000f000f
    s_nop 5
    v_cvt_pk_bf16_f32 v136, v170, v171
    v_cvt_pk_bf16_f32 v137, v172, v173
    v_cvt_pk_bf16_f32 v138, v174, v175
    v_cvt_pk_bf16_f32 v139, v176, v177
    v_lshlrev_b32 v170, 16, v136
    v_and_b32 v171, 0xffff0000, v136
    v_lshlrev_b32 v172, 16, v137
    v_and_b32 v173, 0xffff0000, v137
    v_lshlrev_b32 v174, 16, v138
    v_and_b32 v175, 0xffff0000, v138
    v_lshlrev_b32 v176, 16, v139
    v_and_b32 v177, 0xffff0000, v139
    v_mul_f32 v170, s26, v170
    v_mul_f32 v171, s26, v171
    v_mul_f32 v172, s26, v172
    v_mul_f32 v173, s26, v173
    v_mul_f32 v174, s26, v174
    v_mul_f32 v175, s26, v175
    v_mul_f32 v176, s26, v176
    v_mul_f32 v177, s26, v177
    v_cvt_pk_bf16_f32 v136, v170, v171
    v_cvt_pk_bf16_f32 v137, v172, v173
    v_cvt_pk_bf16_f32 v138, v174, v175
    v_cvt_pk_bf16_f32 v139, v176, v177
    v_lshlrev_b32 v170, 16, v136
    v_and_b32 v171, 0xffff0000, v136
    v_lshlrev_b32 v172, 16, v137
    v_and_b32 v173, 0xffff0000, v137
    v_lshlrev_b32 v174, 16, v138
    v_and_b32 v175, 0xffff0000, v138
    v_lshlrev_b32 v176, 16, v139
    v_and_b32 v177, 0xffff0000, v139
    v_max3_f32 v140, v170, v171, v172
    v_max3_f32 v141, v173, v174, v175
    v_max3_f32 v140, v140, v176, v177
    v_max_f32 v140, v140, v141
    v_mov_b32 v141, v140
    s_nop 1
    v_permlane16_swap_b32 v140, v141
    s_nop 0
    v_max_f32 v140, v140, v141
    v_mov_b32 v141, v140
    s_nop 1
    v_permlane32_swap_b32 v140, v141
    s_nop 0
    v_max_f32 v140, v140, v141
    s_mov_b32 s26, 0x3fb8aa3b
    v_sub_f32 v170, v170, v140
    v_sub_f32 v171, v171, v140
    v_sub_f32 v172, v172, v140
    v_sub_f32 v173, v173, v140
    v_sub_f32 v174, v174, v140
    v_sub_f32 v175, v175, v140
    v_sub_f32 v176, v176, v140
    v_sub_f32 v177, v177, v140
    v_mul_f32 v170, s26, v170
    v_mul_f32 v171, s26, v171
    v_mul_f32 v172, s26, v172
    v_mul_f32 v173, s26, v173
    v_mul_f32 v174, s26, v174
    v_mul_f32 v175, s26, v175
    v_mul_f32 v176, s26, v176
    v_mul_f32 v177, s26, v177
    v_exp_f32 v170, v170
    v_exp_f32 v171, v171
    v_exp_f32 v172, v172
    v_exp_f32 v173, v173
    v_exp_f32 v174, v174
    v_exp_f32 v175, v175
    v_exp_f32 v176, v176
    v_exp_f32 v177, v177
    s_nop 0
    v_cvt_pk_bf16_f32 v136, v170, v171
    v_cvt_pk_bf16_f32 v137, v172, v173
    v_cvt_pk_bf16_f32 v138, v174, v175
    v_cvt_pk_bf16_f32 v139, v176, v177
    v_add_f32 v142, v170, v171
    v_add_f32 v143, v172, v173
    v_add_f32 v144, v174, v175
    v_add_f32 v145, v176, v177
    s_mov_b64 exec, s[36:37]
    ds_write_b128 v117, v[136:139] offset:3584
    s_mov_b64 exec, -1
    v_add_f32 v142, v142, v143
    v_add_f32 v144, v144, v145
    v_add_f32 v142, v142, v144
    v_mov_b32 v143, v142
    s_nop 1
    v_permlane16_swap_b32 v142, v143
    s_nop 0
    v_add_f32 v142, v142, v143
    v_mov_b32 v143, v142
    s_nop 1
    v_permlane32_swap_b32 v142, v143
    s_nop 0
    v_add_f32 v142, v142, v143
    s_mov_b64 exec, 0xf
    ds_write_b32 v118, v140 offset:11776
    ds_write_b32 v118, v142 offset:11840
    s_mov_b64 exec, 1
    ds_write_b32 v38, v39 offset:3120
    s_mov_b64 exec, -1
    s_branch L_join3
L_bwave:
    s_lshl_b32 s26, s20, 23
    s_lshl_b32 s27, s21, 15
    s_add_u32 s26, s26, s27
    s_sub_u32 s27, s25, 4
    s_lshl_b32 s27, s27, 13
    s_add_u32 s26, s26, s27
    s_add_u32 s26, s26, 7340032
    s_add_u32 s30, s6, s26
    s_addc_u32 s31, s7, 0
    s_add_u32 s32, s8, s26
    s_addc_u32 s33, s9, 0
    v_and_b32 v6, 15, v1
    v_lshrrev_b32 v7, 4, v1
    v_xor_b32 v8, v6, v7
    v_lshlrev_b32 v8, 4, v8
    v_lshl_add_u32 v8, v7, 8, v8
    v_lshlrev_b32 v9, 1, v7
    v_xor_b32 v9, v6, v9
    v_lshlrev_b32 v9, 4, v9
    v_lshl_add_u32 v9, v7, 8, v9
    v_xor_b32 v10, 0, v8
    v_xor_b32 v18, 0, v9
    v_xor_b32 v11, 64, v8
    v_xor_b32 v19, 128, v9
    v_xor_b32 v12, 128, v8
    v_xor_b32 v20, 0, v9
    v_xor_b32 v13, 192, v8
    v_xor_b32 v21, 128, v9
    v_xor_b32 v14, 0, v8
    v_add_u32 v14, 4096, v14
    v_xor_b32 v22, 0, v9
    v_add_u32 v22, 4096, v22
    v_xor_b32 v15, 64, v8
    v_add_u32 v15, 4096, v15
    v_xor_b32 v23, 128, v9
    v_add_u32 v23, 4096, v23
    v_xor_b32 v16, 128, v8
    v_add_u32 v16, 4096, v16
    v_xor_b32 v24, 0, v9
    v_add_u32 v24, 4096, v24
    v_xor_b32 v17, 192, v8
    v_add_u32 v17, 4096, v17
    v_xor_b32 v25, 128, v9
    v_add_u32 v25, 4096, v25
    v_lshlrev_b32 v38, 2, v2
    v_mov_b32 v39, 1
    s_add_u32 m0, s27, 29696
    s_nop 0
    global_load_lds_dwordx4 v10, s[30:31] offset:0 nt
    global_load_lds_dwordx4 v11, s[30:31] offset:1024 nt
    global_load_lds_dwordx4 v12, s[30:31] offset:2048 nt
    global_load_lds_dwordx4 v13, s[30:31] offset:3072 nt
    s_add_u32 m0, s27, 33792
    s_nop 0
    s_waitcnt vmcnt(3)
    global_load_lds_dwordx4 v14, s[30:31] offset:0 nt
    s_waitcnt vmcnt(3)
    global_load_lds_dwordx4 v15, s[30:31] offset:1024 nt
    s_waitcnt vmcnt(3)
    global_load_lds_dwordx4 v16, s[30:31] offset:2048 nt
    s_waitcnt vmcnt(3)
    global_load_lds_dwordx4 v17, s[30:31] offset:3072 nt
    s_add_u32 m0, s27, 62464
    s_nop 0
    s_waitcnt vmcnt(3)
    global_load_lds_dwordx4 v18, s[32:33] offset:0 nt
    s_waitcnt vmcnt(3)
    global_load_lds_dwordx4 v19, s[32:33] offset:1024 nt
    s_waitcnt vmcnt(3)
    global_load_lds_dwordx4 v20, s[32:33] offset:2048 nt
    s_waitcnt vmcnt(3)
    s_mov_b64 exec, 1
    ds_write_b32 v38, v39 offset:3072
    s_mov_b64 exec, -1
    global_load_lds_dwordx4 v21, s[32:33] offset:3072 nt
    s_add_u32 m0, s27, 66560
    s_nop 0
    s_waitcnt vmcnt(3)
    global_load_lds_dwordx4 v22, s[32:33] offset:0 nt
    s_waitcnt vmcnt(3)
    s_mov_b64 exec, 1
    ds_write_b32 v38, v39 offset:3136
    s_mov_b64 exec, -1
    global_load_lds_dwordx4 v23, s[32:33] offset:1024 nt
    s_waitcnt vmcnt(3)
    global_load_lds_dwordx4 v24, s[32:33] offset:2048 nt
    s_waitcnt vmcnt(3)
    global_load_lds_dwordx4 v25, s[32:33] offset:3072 nt
    s_waitcnt vmcnt(16)
    v_readfirstlane_b32 s23, v4
    s_mul_i32 s22, s23, 0x9E3779B1
    s_add_u32 s22, s22, 0x7F4A7C15
    v_lshrrev_b32 v7, 4, v1
    v_bfe_u32 v9, v1, 2, 2
    v_lshl_add_u32 v8, v7, 2, v9
    v_lshlrev_b32 v119, 4, v8
    v_and_b32 v9, 7, v8
    v_lshlrev_b32 v9, 1, v9
    v_bfe_u32 v10, v1, 1, 1
    v_xor_b32 v9, v9, v10
    v_lshlrev_b32 v10, 1, v2
    v_xor_b32 v9, v9, v10
    v_lshlrev_b32 v116, 8, v8
    v_lshl_add_u32 v116, v9, 4, v116
    v_and_b32 v10, 1, v1
    v_lshl_add_u32 v116, v10, 3, v116
    v_add_u32 v116, 62464, v116
    v_lshlrev_b32 v146, 2, v7
    s_lshl_b32 s27, s20, 17
    s_lshl_b32 s28, s21, 10
    s_add_u32 s27, s27, s28
    s_add_u32 s27, s27, 65536
    v_and_b32 v149, 15, v1
    v_lshl_add_u32 v147, v2, 4, v149
    v_lshlrev_b32 v147, 3, v147
    v_lshl_add_u32 v147, v7, 15, v147
    v_add_u32 v147, s27, v147
    s_lshl_b32 s27, s20, 11
    s_lshl_b32 s28, s21, 4
    s_add_u32 s27, s27, s28
    s_add_u32 s27, s27, 32768
    v_lshlrev_b32 v148, 9, v7
    v_add_u32 v148, s27, v148
    v_mov_b32 v151, s22
    v_mov_b32 v153, s22
    v_mov_b32 v155, s22
    v_mov_b32 v157, s22
    s_mov_b32 s44, 0x55555555
    s_mov_b32 s45, 0x55555555
    s_mov_b32 s46, 0x00010001
    s_mov_b32 s47, 0x00010001
    v_add_u32 v196, 4194304, v147
    v_add_u32 v197, 4194304, v148
    s_not_b32 s27, s22
    v_mov_b32 v198, 0
    v_mov_b32 v199, s27
    v_mov_b32 v200, 0
    v_mov_b32 v201, s27
    s_mov_b64 exec, s[44:45]
    global_store_dwordx4 v196, v[198:201], s[18:19]
    s_cmp_eq_u32 s25, 0
    s_cselect_b64 exec, s[46:47], 0
    global_store_dwordx4 v197, v[198:201], s[18:19]
    s_mov_b64 exec, -1
L_pw0:
    ds_read_b128 v[56:59], v3 offset:3120
    s_waitcnt lgkmcnt(0)
    v_or3_b32 v56, v56, v57, v58
    v_or_b32 v56, v56, v59
    s_nop 0
    v_readfirstlane_b32 s27, v56
    s_cmp_lg_u32 s27, 0
    s_cbranch_scc1 L_join3
    s_sleep 1
    s_branch L_pw0
L_join3:
    s_mov_b32 s26, 0x3fb8aa3b
L_pw:
    ds_read_b128 v[56:59], v3 offset:3120
    ds_read_b32 v20, v146 offset:11776
    ds_read_b32 v21, v146 offset:11792
    ds_read_b32 v22, v146 offset:11808
    ds_read_b32 v23, v146 offset:11824
    ds_read_b32 v30, v146 offset:11840
    ds_read_b32 v31, v146 offset:11856
    ds_read_b32 v32, v146 offset:11872
    ds_read_b32 v33, v146 offset:11888
    ds_read_b128 v[72:75], v119 offset:3584
    ds_read_b128 v[76:79], v119 offset:3840
    ds_read_b128 v[80:83], v119 offset:4096
    ds_read_b128 v[84:87], v119 offset:4352
    s_waitcnt lgkmcnt(12)
    v_and_b32 v56, v56, v57
    v_and_b32 v58, v58, v59
    v_and_b32 v56, v56, v58
    s_waitcnt lgkmcnt(8)
    v_readfirstlane_b32 s27, v56
    v_max3_f32 v154, v20, v21, v22
    s_cmp_eq_u32 s27, 0
    s_cbranch_scc0 L_pwok
    s_waitcnt lgkmcnt(0)
    s_branch L_pw
L_pwok:
    v_max_f32 v154, v154, v23
    v_sub_f32 v20, v20, v154
    v_sub_f32 v21, v21, v154
    v_sub_f32 v22, v22, v154
    v_sub_f32 v23, v23, v154
    v_mul_f32 v20, s26, v20
    v_mul_f32 v21, s26, v21
    v_mul_f32 v22, s26, v22
    v_mul_f32 v23, s26, v23
    v_exp_f32 v20, v20
    v_exp_f32 v21, v21
    v_exp_f32 v22, v22
    v_exp_f32 v23, v23
    s_waitcnt lgkmcnt(4)
    s_cmp_lg_u32 s25, 0
    s_cbranch_scc1 L_noml
    v_mul_f32 v156, v20, v30
    v_fmac_f32 v156, v21, v31
    v_fmac_f32 v156, v22, v32
    v_fmac_f32 v156, v23, v33
    s_mov_b64 exec, s[46:47]
    global_store_dwordx4 v197, v[154:157], s[18:19]
    s_mov_b64 exec, -1
L_noml:
    s_lshl_b32 s48, s34, 17
    s_lshl_b32 s49, s35, 14
    s_add_u32 s48, s48, s49
    v_lshlrev_b32 v158, 11, v2
    v_lshl_add_u32 v158, v1, 4, v158
    v_add_u32 v158, s48, v158
    global_load_dwordx4 v[104:107], v158, s[12:13] nt
    global_load_dwordx4 v[108:111], v158, s[12:13] offset:1024 nt
    s_cmp_lt_u32 s25, 4
    s_cbranch_scc1 L_nowv
    s_waitcnt vmcnt(2)
L_nowv:
    s_barrier
    ds_read_b64_tr_b16 v[40:41], v116 offset:0
    ds_read_b64_tr_b16 v[42:43], v116 offset:4096
    ds_read_b64_tr_b16 v[44:45], v116 offset:8192
    ds_read_b64_tr_b16 v[46:47], v116 offset:12288
    ds_read_b64_tr_b16 v[48:49], v116 offset:16384
    ds_read_b64_tr_b16 v[50:51], v116 offset:20480
    ds_read_b64_tr_b16 v[52:53], v116 offset:24576
    ds_read_b64_tr_b16 v[54:55], v116 offset:28672
    s_waitcnt lgkmcnt(6)
    v_mfma_f32_16x16x32_bf16 v[180:183], v[72:75], v[40:43], 0
    s_waitcnt lgkmcnt(4)
    v_mfma_f32_16x16x32_bf16 v[184:187], v[76:79], v[44:47], 0
    s_waitcnt lgkmcnt(2)
    v_mfma_f32_16x16x32_bf16 v[188:191], v[80:83], v[48:51], 0
    s_waitcnt lgkmcnt(0)
    v_mfma_f32_16x16x32_bf16 v[192:195], v[84:87], v[52:55], 0
    s_nop 4
    v_mul_f32 v150, v20, v180
    v_fmac_f32 v150, v21, v184
    v_fmac_f32 v150, v22, v188
    v_fmac_f32 v150, v23, v192
    s_nop 1
    v_mov_b32_dpp v152, v150 quad_perm:[1,0,3,2] row_mask:0xf bank_mask:0xf
    s_mov_b64 exec, s[44:45]
    global_store_dwordx4 v196, v[150:153], s[18:19]
    s_mov_b64 exec, -1
    s_lshl_b32 s26, s34, 9
    s_add_u32 s26, s26, 32768
    v_and_b32 v5, 31, v1
    v_lshlrev_b32 v5, 4, v5
    v_add_u32 v5, s26, v5
    s_lshl_b32 s26, s34, 15
    s_lshl_b32 s27, s35, 7
    s_add_u32 s26, s26, s27
    s_add_u32 s26, s26, 65536
    v_and_b32 v7, 31, v1
    v_lshlrev_b32 v6, 10, v7
    v_lshl_add_u32 v6, v2, 4, v6
    v_add_u32 v6, s26, v6
    v_lshlrev_b32 v21, 11, v2
    v_lshl_add_u32 v21, v1, 5, v21
    v_xor_b32 v18, 16, v1
    v_lshlrev_b32 v18, 2, v18
    v_xor_b32 v19, 32, v1
    v_lshlrev_b32 v19, 2, v19
    v_add_u32 v26, 4194304, v5
    v_add_u32 v27, 4194304, v6
    s_mov_b32 exec_hi, 0
L_fp:
    global_load_dwordx4 v[8:11], v26, s[18:19] sc1
    global_load_dwordx4 v[12:15], v27, s[18:19] sc1
    s_memrealtime s[40:41]
    s_waitcnt vmcnt(0) lgkmcnt(0)
    v_xor_b32 v168, s22, v9
    v_xor_b32 v169, s22, v11
    v_or_b32 v168, v168, v169
    v_xor_b32 v169, s22, v13
    v_or_b32 v168, v168, v169
    v_xor_b32 v169, s22, v15
    v_or_b32 v168, v168, v169
    v_cmp_ne_u32 vcc, 0, v168
    s_sub_u32 s40, s40, s42
    s_nop 0
    s_cmp_eq_u64 vcc, 0
    s_cbranch_scc1 L_fpok
    s_mov_b64 exec, vcc
    s_cmp_lt_u32 s40, 2000
    s_cbranch_scc1 L_fp
    s_mov_b64 exec, s[44:45]
    global_store_dwordx4 v147, v[150:153], s[18:19] sc1
    s_cmp_eq_u32 s25, 0
    s_cselect_b64 exec, s[46:47], 0
    global_store_dwordx4 v148, v[154:157], s[18:19] sc1
    s_mov_b64 exec, -1
    s_mov_b32 s38, 0
L_poll_p:
    global_load_dwordx4 v[8:11], v5, s[18:19] sc1
    global_load_dwordx4 v[12:15], v6, s[18:19] sc1
    s_waitcnt vmcnt(0)
    v_xor_b32 v168, s22, v9
    v_xor_b32 v169, s22, v11
    v_or_b32 v168, v168, v169
    v_xor_b32 v169, s22, v13
    v_or_b32 v168, v168, v169
    v_xor_b32 v169, s22, v15
    v_or_b32 v168, v168, v169
    v_cmp_ne_u32 vcc, 0, v168
    s_nop 1
    s_cmp_eq_u64 vcc, 0
    s_cbranch_scc1 L_pollok_p
    s_add_u32 s38, s38, 1
    s_cmp_lt_u32 s38, 0x40000
    s_cbranch_scc0 L_pollok_p
    s_sleep 1
    s_branch L_poll_p
L_pollok_p:
    s_branch L_fpok2
L_fpok:
    s_mov_b64 exec, s[44:45]
    global_store_dwordx4 v147, v[150:153], s[18:19] sc1
    s_cmp_eq_u32 s25, 0
    s_cselect_b64 exec, s[46:47], 0
    global_store_dwordx4 v148, v[154:157], s[18:19] sc1
    s_mov_b64 exec, -1
L_fpok2:
    v_mov_b32 v16, v8
    v_lshlrev_b32 v40, 16, v104
    v_and_b32 v41, 0xffff0000, v104
    v_max_f32_dpp v16, v16, v16 quad_perm:[1,0,3,2] row_mask:0xf bank_mask:0xf
    v_lshlrev_b32 v48, 16, v108
    v_and_b32 v49, 0xffff0000, v108
    v_max_f32_dpp v16, v16, v16 quad_perm:[2,3,0,1] row_mask:0xf bank_mask:0xf
    v_lshlrev_b32 v42, 16, v105
    v_and_b32 v43, 0xffff0000, v105
    v_max_f32_dpp v16, v16, v16 row_ror:4 row_mask:0xf bank_mask:0xf
    v_lshlrev_b32 v50, 16, v109
    v_and_b32 v51, 0xffff0000, v109
    v_max_f32_dpp v16, v16, v16 row_ror:8 row_mask:0xf bank_mask:0xf
    v_mov_b32 v17, v16
    v_lshlrev_b32 v44, 16, v106
    v_and_b32 v45, 0xffff0000, v106
    v_permlane16_swap_b32 v16, v17
    s_mov_b32 s26, 0x3fb8aa3b
    v_max_f32 v16, v16, v17
    v_sub_f32 v8, v8, v16
    v_mul_f32 v8, s26, v8
    v_exp_f32 v8, v8
    v_lshlrev_b32 v52, 16, v110
    v_and_b32 v53, 0xffff0000, v110
    v_mul_f32 v12, v8, v12
    v_mul_f32 v14, v8, v14
    v_mul_f32 v10, v8, v10
    v_add_f32_dpp v12, v12, v12 quad_perm:[1,0,3,2] row_mask:0xf bank_mask:0xf
    v_add_f32_dpp v14, v14, v14 quad_perm:[1,0,3,2] row_mask:0xf bank_mask:0xf
    v_add_f32_dpp v10, v10, v10 quad_perm:[1,0,3,2] row_mask:0xf bank_mask:0xf
    v_add_f32_dpp v12, v12, v12 quad_perm:[2,3,0,1] row_mask:0xf bank_mask:0xf
    v_add_f32_dpp v14, v14, v14 quad_perm:[2,3,0,1] row_mask:0xf bank_mask:0xf
    v_add_f32_dpp v10, v10, v10 quad_perm:[2,3,0,1] row_mask:0xf bank_mask:0xf
    v_add_f32_dpp v12, v12, v12 row_ror:4 row_mask:0xf bank_mask:0xf
    v_add_f32_dpp v14, v14, v14 row_ror:4 row_mask:0xf bank_mask:0xf
    v_add_f32_dpp v10, v10, v10 row_ror:4 row_mask:0xf bank_mask:0xf
    v_add_f32_dpp v12, v12, v12 row_ror:8 row_mask:0xf bank_mask:0xf
    v_add_f32_dpp v14, v14, v14 row_ror:8 row_mask:0xf bank_mask:0xf
    v_add_f32_dpp v10, v10, v10 row_ror:8 row_mask:0xf bank_mask:0xf
    v_mov_b32 v13, v12
    v_mov_b32 v15, v14
    v_mov_b32 v11, v10
    v_permlane16_swap_b32 v12, v13
    v_permlane16_swap_b32 v14, v15
    v_permlane16_swap_b32 v10, v11
    s_nop 0
    v_add_f32 v12, v12, v13
    v_add_f32 v14, v14, v15
    v_add_f32 v10, v10, v11
    v_rcp_f32 v10, v10
    v_lshlrev_b32 v46, 16, v107
    v_and_b32 v47, 0xffff0000, v107
    v_lshlrev_b32 v54, 16, v111
    v_and_b32 v55, 0xffff0000, v111
    v_mul_f32 v12, v12, v10
    v_mul_f32 v14, v14, v10
    v_cvt_pk_bf16_f32 v136, v12, v14
    v_mov_b32 v5, v21
    v_readfirstlane_b32 s27, v136
    s_lshl_b32 s28, s27, 16
    s_and_b32 s27, s27, 0xffff0000
    v_mov_b32 v24, s28
    v_mov_b32 v25, s27
    v_mul_f32 v28, v24, v40
    v_mul_f32 v29, v24, v41
    v_mul_f32 v30, v24, v42
    v_mul_f32 v31, v24, v43
    v_mul_f32 v32, v24, v44
    v_mul_f32 v33, v24, v45
    v_mul_f32 v34, v24, v46
    v_mul_f32 v35, v24, v47
    v_fmac_f32 v28, v25, v48
    v_fmac_f32 v29, v25, v49
    v_fmac_f32 v30, v25, v50
    v_fmac_f32 v31, v25, v51
    v_fmac_f32 v32, v25, v52
    v_fmac_f32 v33, v25, v53
    v_fmac_f32 v34, v25, v54
    v_fmac_f32 v35, v25, v55
    ds_write_b128 v5, v[28:31] offset:12928
    ds_write_b128 v5, v[32:35] offset:12944
    v_lshlrev_b32 v5, 2, v0
    s_lshl_b32 s26, s2, 12
    s_add_u32 s26, s26, 1179648
    v_lshlrev_b32 v6, 3, v0
    v_add_u32 v6, s26, v6
    v_mov_b32 v9, s22
    s_waitcnt lgkmcnt(0)
    s_barrier
    ds_read_b32 v136, v5 offset:12928
    ds_read_b32 v137, v5 offset:14976
    ds_read_b32 v138, v5 offset:17024
    ds_read_b32 v139, v5 offset:19072
    ds_read_b32 v140, v5 offset:21120
    ds_read_b32 v141, v5 offset:23168
    ds_read_b32 v142, v5 offset:25216
    ds_read_b32 v143, v5 offset:27264
    s_waitcnt lgkmcnt(0)
    v_add_f32 v136, v136, v140
    v_add_f32 v137, v137, v141
    v_add_f32 v138, v138, v142
    v_add_f32 v139, v139, v143
    v_add_f32 v136, v136, v138
    v_add_f32 v137, v137, v139
    v_add_f32 v136, v136, v137
    v_mov_b32 v8, v136
    v_mov_b32 v11, s22
    s_mov_b32 s36, 0x55555555
    s_mov_b32 s37, 0x55555555
    v_mov_b32_dpp v10, v136 quad_perm:[1,0,3,2] row_mask:0xf bank_mask:0xf
    s_mov_b64 exec, s[36:37]
    global_store_dwordx4 v6, v[8:11], s[18:19] sc1
    s_mov_b64 exec, -1
    s_cmp_ge_u32 s21, 8
    s_cbranch_scc1 L_end
    s_lshl_b32 s28, s20, 3
    s_add_u32 s28, s28, s21
    s_lshl_b32 s26, s28, 6
    s_add_u32 s26, s26, 1179648
    v_lshrrev_b32 v5, 1, v0
    v_lshlrev_b32 v5, 12, v5
    v_and_b32 v6, 1, v0
    v_lshl_add_u32 v5, v6, 5, v5
    v_add_u32 v5, s26, v5
    s_barrier
    s_mov_b32 s38, 0
L_poll_f:
    global_load_dwordx4 v[136:139], v5, s[18:19] sc1
    global_load_dwordx4 v[140:143], v5, s[18:19] offset:16 sc1
    s_waitcnt vmcnt(0)
    v_xor_b32 v168, s22, v137
    v_xor_b32 v169, s22, v139
    v_or_b32 v168, v168, v169
    v_xor_b32 v169, s22, v141
    v_or_b32 v168, v168, v169
    v_xor_b32 v169, s22, v143
    v_or_b32 v168, v168, v169
    v_cmp_ne_u32 vcc, 0, v168
    s_nop 1
    s_cmp_eq_u64 vcc, 0
    s_cbranch_scc1 L_pollok_f
    s_mov_b64 exec, vcc
    s_add_u32 s38, s38, 1
    s_cmp_lt_u32 s38, 0x40000
    s_cbranch_scc0 L_pollok_f
    s_sleep 1
    s_branch L_poll_f
L_pollok_f:
    s_mov_b64 exec, -1
    s_nop 0
    v_add_f32_dpp v136, v136, v136 quad_perm:[2,3,0,1] row_mask:0xf bank_mask:0xf
    v_add_f32_dpp v138, v138, v138 quad_perm:[2,3,0,1] row_mask:0xf bank_mask:0xf
    v_add_f32_dpp v140, v140, v140 quad_perm:[2,3,0,1] row_mask:0xf bank_mask:0xf
    v_add_f32_dpp v142, v142, v142 quad_perm:[2,3,0,1] row_mask:0xf bank_mask:0xf
    s_nop 1
    v_add_f32_dpp v136, v136, v136 row_ror:4 row_mask:0xf bank_mask:0xf
    v_add_f32_dpp v138, v138, v138 row_ror:4 row_mask:0xf bank_mask:0xf
    v_add_f32_dpp v140, v140, v140 row_ror:4 row_mask:0xf bank_mask:0xf
    v_add_f32_dpp v142, v142, v142 row_ror:4 row_mask:0xf bank_mask:0xf
    s_nop 1
    v_add_f32_dpp v136, v136, v136 row_ror:8 row_mask:0xf bank_mask:0xf
    v_add_f32_dpp v138, v138, v138 row_ror:8 row_mask:0xf bank_mask:0xf
    v_add_f32_dpp v140, v140, v140 row_ror:8 row_mask:0xf bank_mask:0xf
    v_add_f32_dpp v142, v142, v142 row_ror:8 row_mask:0xf bank_mask:0xf
    s_nop 1
    v_mov_b32 v170, v136
    v_mov_b32 v171, v138
    v_mov_b32 v172, v140
    v_mov_b32 v173, v142
    v_permlane16_swap_b32 v136, v170
    v_permlane16_swap_b32 v138, v171
    v_permlane16_swap_b32 v140, v172
    v_permlane16_swap_b32 v142, v173
    s_nop 0
    v_add_f32 v136, v136, v170
    v_add_f32 v138, v138, v171
    v_add_f32 v140, v140, v172
    v_add_f32 v142, v142, v173
    v_mov_b32 v170, v136
    v_mov_b32 v171, v138
    v_mov_b32 v172, v140
    v_mov_b32 v173, v142
    v_permlane32_swap_b32 v136, v170
    v_permlane32_swap_b32 v138, v171
    v_permlane32_swap_b32 v140, v172
    v_permlane32_swap_b32 v142, v173
    s_nop 0
    v_add_f32 v136, v136, v170
    v_add_f32 v138, v138, v171
    v_add_f32 v140, v140, v172
    v_add_f32 v142, v142, v173
    v_mov_b32 v137, v138
    v_mov_b32 v138, v140
    v_mov_b32 v139, v142
    v_lshlrev_b32 v5, 5, v2
    v_lshl_add_u32 v5, v6, 4, v5
    s_mov_b64 exec, 3
    ds_write_b128 v5, v[136:139] offset:12416
    s_mov_b64 exec, -1
    s_waitcnt lgkmcnt(0)
    s_barrier
    s_cmp_lg_u32 s25, 0
    s_cbranch_scc1 L_end
    v_and_b32 v6, 3, v1
    v_lshlrev_b32 v5, 3, v6
    ds_read_b64 v[136:137], v5 offset:12416
    ds_read_b64 v[138:139], v5 offset:12448
    ds_read_b64 v[140:141], v5 offset:12480
    ds_read_b64 v[142:143], v5 offset:12512
    ds_read_b64 v[144:145], v5 offset:12544
    ds_read_b64 v[146:147], v5 offset:12576
    ds_read_b64 v[148:149], v5 offset:12608
    ds_read_b64 v[150:151], v5 offset:12640
    s_lshl_b32 s26, s28, 4
    v_lshlrev_b32 v5, 2, v6
    v_add_u32 v5, s26, v5
    s_waitcnt lgkmcnt(0)
    v_add_f32 v136, v136, v144
    v_add_f32 v137, v137, v145
    v_add_f32 v138, v138, v146
    v_add_f32 v139, v139, v147
    v_add_f32 v140, v140, v148
    v_add_f32 v141, v141, v149
    v_add_f32 v142, v142, v150
    v_add_f32 v143, v143, v151
    v_add_f32 v136, v136, v140
    v_add_f32 v137, v137, v141
    v_add_f32 v138, v138, v142
    v_add_f32 v139, v139, v143
    v_add_f32 v136, v136, v138
    v_add_f32 v137, v137, v139
    v_cvt_pk_bf16_f32 v8, v136, v137
    s_mov_b64 exec, 0xf
    global_store_dword v5, v8, s[14:15]
    s_cmp_lg_u32 s28, 0
    s_cbranch_scc1 L_end
    s_add_u32 s26, s23, 1
    v_mov_b32 v9, s26
    v_mov_b32 v5, 0
    s_mov_b64 exec, 1
    global_store_dword v5, v9, s[18:19] sc1
L_end:
L_exit:
    s_endpgm
.section .rodata,"a"
.p2align 6
.amdhsa_kernel standalone__sliding_block_cached__decode_kernel
  .amdhsa_next_free_vgpr 240
  .amdhsa_next_free_sgpr 100
  .amdhsa_accum_offset 240
  .amdhsa_group_segment_fixed_size 0
  .amdhsa_kernarg_size 64
  .amdhsa_user_sgpr_count 2
  .amdhsa_user_sgpr_kernarg_segment_ptr 1
  .amdhsa_system_sgpr_workgroup_id_x 1
.end_amdhsa_kernel
```
